```python
import torch

def _softmax(x, axis=-1):
    return torch.softmax(x, dim=axis)
def _gelu(x):
    return torch.nn.functional.gelu(x, approximate="tanh")
def _silu(x):
    return torch.nn.functional.silu(x)
def _sigmoid(x):
    return torch.sigmoid(x)
def _layernorm(x, axis=-1, eps=1e-5):
    m = x.mean(dim=axis, keepdim=True)
    v = x.var(dim=axis, keepdim=True, unbiased=False)
    return (x - m) / torch.sqrt(v + eps)
def _scatter_add(tgt, idx, src, axis=0):
    return tgt.clone().index_add_(axis, idx, src)
def _segment_sum(src, seg, n):
    out = torch.zeros((n,) + src.shape[1:], dtype=src.dtype)
    return out.index_add_(0, seg, src)
def _pad(x, pw):
    flat = tuple(v for pair in reversed(pw) for v in pair)
    return torch.nn.functional.pad(x, flat)

kernel_name = 'standalone__gqa_softmax__near_ridge'

def setup_inputs():

    _w = (lambda a: (lambda t: t.to(torch.bfloat16) if t.is_floating_point() else t)(torch.as_tensor(a)))
    B, Hq, Hkv, Sq, Sk, D = 8, 32, 4, 32, 2048, 128
    return {
        "q": _w((lambda *s: torch.randn(*s, dtype=torch.bfloat16) * 0.8)(B, Hq, Sq, D)),
        "k": _w((lambda *s: torch.randn(*s, dtype=torch.bfloat16) * 0.8)(B, Hkv, Sk, D)),
        "v": _w((lambda *s: torch.randn(*s, dtype=torch.bfloat16) * 0.05)(B, Hkv, Sk, D)),
    }

def reference(q, k, v):
    B, Hq, Sq, D = q.shape
    Hkv = k.shape[1]
    rep = Hq // Hkv
    k = (lambda x, n, axis: torch.repeat_interleave(x, n, dim=axis))(k, rep, axis=1)
    v = (lambda x, n, axis: torch.repeat_interleave(x, n, dim=axis))(v, rep, axis=1)
    scale = D ** -0.5
    scores = torch.einsum("bhqd,bhkd->bhqk", q, k) * scale
    p = _softmax(scores, axis=-1)
    return torch.einsum("bhqk,bhkd->bhqd", p, v)
```

```asm
; @launch grid=(256,1,1) block=(512,1,1) lds=163840
.amdgcn_target "amdgcn-amd-amdhsa--gfx950"
.text
.globl standalone__gqa_softmax__near_ridge_kernel
.p2align 8
.type standalone__gqa_softmax__near_ridge_kernel,@function
standalone__gqa_softmax__near_ridge_kernel:
    s_cmp_ge_u32 s2, 0x100
    s_cbranch_scc1 L_end
    s_load_dwordx8 s[4:11], s[0:1], 0
    s_load_dwordx4 s[12:15], s[0:1], 32
    v_lshrrev_b32 v1, 6, v0
    v_and_b32 v199, 63, v0
    v_readfirstlane_b32 s40, v1
    s_and_b32 s49, s2, 7
    s_lshr_b32 s54, s2, 3
    s_lshl_b32 s41, s49, 2
    s_lshr_b32 s55, s54, 3
    s_add_u32 s41, s41, s55
    s_and_b32 s42, s54, 3
    s_bfe_u32 s43, s54, 0x10002
    s_and_b32 s44, s40, 3
    s_lshr_b32 s45, s40, 2
    s_lshl_b32 s46, s41, 19
    s_lshl_b32 s49, s42, 17
    s_add_u32 s46, s46, s49
    s_lshl_b32 s49, s45, 13
    s_add_u32 s46, s46, s49
    s_lshl_b32 s51, s41, 1
    s_add_u32 s51, s51, s43
    s_lshl_b32 s47, s51, 15
    s_lshl_b32 s49, s45, 14
    s_add_u32 s47, s47, s49
    s_lshl_b32 s55, s44, 11
    s_add_u32 s56, s55, s49
    s_add_u32 s50, s56, 0x20000
    s_lshl_b32 s48, s45, 16
    s_add_u32 s48, s48, s55
    v_lshrrev_b32 v1, 4, v199
    s_lshl_b32 s49, s44, 3
    v_add_u32 v1, s49, v1
    v_and_b32 v2, 15, v199
    v_and_b32 v3, 15, v1
    v_xor_b32 v3, v2, v3
    v_lshlrev_b32 v3, 4, v3
    v_lshl_add_u32 v196, v1, 8, v3
    v_xor_b32 v197, 64, v196
    v_and_b32 v3, 3, v1
    v_lshlrev_b32 v3, 2, v3
    v_xor_b32 v3, v2, v3
    v_lshlrev_b32 v3, 4, v3
    v_lshl_add_u32 v198, v1, 8, v3
    s_mov_b32 s18, 0x1000000
    s_mov_b32 s19, 0x20000
    s_mov_b32 s26, 0x200000
    s_mov_b32 s27, 0x20000
    s_mov_b32 s22, 0x1000000
    s_mov_b32 s23, 0x20000
    s_waitcnt lgkmcnt(0)
    s_mov_b32 s16, s6
    s_and_b32 s17, s7, 0xffff
    s_mov_b32 s24, s4
    s_and_b32 s25, s5, 0xffff
    s_mov_b32 s20, s8
    s_and_b32 s21, s9, 0xffff
    s_add_u32 m0, s56, 0x20000
    s_add_u32 s49, s47, 0x0
    buffer_load_dwordx4 v196, s[24:27], s49 offen nt lds
    buffer_load_dwordx4 v197, s[24:27], s49 offen offset:1024 nt lds
    s_add_u32 m0, s56, 0x22000
    s_add_u32 s49, s47, 0x2000
    buffer_load_dwordx4 v196, s[24:27], s49 offen nt lds
    buffer_load_dwordx4 v197, s[24:27], s49 offen offset:1024 nt lds
    s_add_u32 m0, s48, 0x0
    s_add_u32 s49, s46, 0x0
    buffer_load_dwordx4 v196, s[16:19], s49 offen nt lds
    buffer_load_dwordx4 v197, s[16:19], s49 offen offset:1024 nt lds
    s_mov_b32 s28, s10
    s_and_b32 s29, s11, 0xffff
    s_mov_b32 s30, 0x200000
    s_mov_b32 s31, 0x20000
    s_mov_b32 s32, s14
    s_and_b32 s33, s15, 0xffff
    s_mov_b32 s34, 0x10000000
    s_mov_b32 s35, 0x20000
    s_mov_b32 s36, s12
    s_and_b32 s37, s13, 0xffff
    s_mov_b32 s38, 0x100
    s_mov_b32 s39, 0x20000
    s_lshl_b32 s52, s51, 2
    s_add_u32 s52, s52, s42
    s_cmp_eq_u32 s40, 0
    s_cselect_b32 s57, 0, 0x40000000
    v_lshlrev_b32 v4, 7, v199
    s_lshl_b32 s54, s51, 12
    s_add_u32 s54, s54, 0x900000
    s_cmp_eq_u32 s42, 0
    s_cselect_b32 s3, s57, 0x40000000
    s_add_u32 s54, s54, s3
    s_mov_b32 exec_hi, 0
    buffer_load_dword v220, v4, s[32:35], s54 offen sc1
    s_mov_b64 exec, -1
    s_lshl_b32 s94, s51, 2
    s_add_u32 s94, s94, s44
    s_lshl_b32 s94, s94, 1
    s_add_u32 s94, s94, s45
    s_lshl_b32 s94, s94, 2
    s_add_u32 s94, s94, s42
    s_lshl_b32 s100, s94, 7
    s_add_u32 s100, s100, 0x900000
    s_lshl_b32 s96, s94, 9
    s_add_u32 s96, s96, 0x800000
    s_lshl_b32 s94, s94, 12
    s_cmp_eq_u32 s44, s42
    s_cselect_b32 s95, 0x40000000, s94
    s_cselect_b32 s97, 0x40000000, s96
    s_cselect_b32 s100, 0x40000000, s100
    v_mov_b32 v216, -1
    v_mov_b32 v217, -1
    v_mov_b32 v218, -1
    v_mov_b32 v219, -1
    v_and_b32 v1, 31, v199
    v_lshrrev_b32 v2, 5, v199
    v_and_b32 v3, 15, v1
    v_xor_b32 v3, v2, v3
    v_lshlrev_b32 v3, 4, v3
    v_lshl_add_u32 v3, v1, 8, v3
    s_lshl_b32 s49, s45, 16
    s_lshl_b32 s54, s44, 13
    s_add_u32 s54, s54, 0x20000
    v_xor_b32 v5, 0x0, v3
    v_add_u32 v184, s49, v5
    v_add_u32 v204, s54, v5
    v_xor_b32 v5, 0x20, v3
    v_add_u32 v185, s49, v5
    v_add_u32 v205, s54, v5
    v_xor_b32 v5, 0x40, v3
    v_add_u32 v186, s49, v5
    v_add_u32 v206, s54, v5
    v_xor_b32 v5, 0x60, v3
    v_add_u32 v187, s49, v5
    v_add_u32 v207, s54, v5
    v_xor_b32 v5, 0x80, v3
    v_add_u32 v188, s49, v5
    v_add_u32 v208, s54, v5
    v_xor_b32 v5, 0xa0, v3
    v_add_u32 v189, s49, v5
    v_add_u32 v209, s54, v5
    v_xor_b32 v5, 0xc0, v3
    v_add_u32 v190, s49, v5
    v_add_u32 v210, s54, v5
    v_xor_b32 v5, 0xe0, v3
    v_add_u32 v191, s49, v5
    v_add_u32 v211, s54, v5
    v_and_b32 v1, 15, v199
    v_lshrrev_b32 v3, 2, v1
    v_lshl_add_u32 v4, v2, 2, v3
    v_lshlrev_b32 v4, 8, v4
    v_bfe_u32 v5, v199, 4, 1
    v_lshl_add_u32 v4, v5, 5, v4
    v_and_b32 v5, 3, v1
    v_lshl_add_u32 v4, v5, 3, v4
    s_add_u32 s49, s49, 0x2000
    v_add_u32 v4, s49, v4
    v_xor_b32 v5, 0, v3
    v_lshl_add_u32 v192, v5, 6, v4
    v_xor_b32 v5, 1, v3
    v_lshl_add_u32 v193, v5, 6, v4
    v_xor_b32 v5, 2, v3
    v_lshl_add_u32 v194, v5, 6, v4
    v_xor_b32 v5, 3, v3
    v_lshl_add_u32 v195, v5, 6, v4
    v_lshlrev_b32 v223, 4, v199
    v_lshlrev_b32 v224, 3, v199
    s_lshl_b32 s49, s40, 9
    s_add_u32 s49, s49, 0xc000
    s_xor_b32 s54, s49, 0x800
    v_add_u32 v225, s49, v224
    v_add_u32 v226, s54, v224
    v_and_b32 v1, 15, v199
    v_bfe_u32 v2, v199, 4, 1
    v_cmp_eq_u32 vcc, v1, v2
    v_mov_b32 v3, 0x3f803f80
    s_nop 0
    v_cndmask_b32 v252, 0, v3, vcc
    v_cndmask_b32 v253, 0, v3, vcc
    v_cndmask_b32 v254, 0, v3, vcc
    v_cndmask_b32 v255, 0, v3, vcc
    v_add_u32 v202, s50, v223
    s_waitcnt vmcnt(3)
    ds_read_b128 v[0:3], v202 offset:0
    ds_read_b128 v[4:7], v202 offset:1024
    ds_read_b128 v[8:11], v202 offset:8192
    ds_read_b128 v[12:15], v202 offset:9216
    s_waitcnt lgkmcnt(3)
    v_lshlrev_b32 v16, 16, v0
    v_and_b32 v17, 0xffff0000, v0
    v_lshlrev_b32 v18, 16, v1
    v_and_b32 v19, 0xffff0000, v1
    v_lshlrev_b32 v20, 16, v2
    v_and_b32 v21, 0xffff0000, v2
    v_lshlrev_b32 v22, 16, v3
    v_and_b32 v23, 0xffff0000, v3
    v_mul_f32 v16, 0x3e0293ee, v16
    v_mul_f32 v17, 0x3e0293ee, v17
    v_mul_f32 v18, 0x3e0293ee, v18
    v_mul_f32 v19, 0x3e0293ee, v19
    v_mul_f32 v20, 0x3e0293ee, v20
    v_mul_f32 v21, 0x3e0293ee, v21
    v_mul_f32 v22, 0x3e0293ee, v22
    v_mul_f32 v23, 0x3e0293ee, v23
    v_cvt_pk_bf16_f32 v0, v16, v17
    v_cvt_pk_bf16_f32 v1, v18, v19
    v_cvt_pk_bf16_f32 v2, v20, v21
    v_cvt_pk_bf16_f32 v3, v22, v23
    ds_write_b128 v202, v[0:3] offset:0
    s_add_u32 m0, s48, 0x2000
    s_add_u32 s49, s46, 0x0
    buffer_load_dwordx4 v198, s[20:23], s49 offen nt lds
    buffer_load_dwordx4 v198, s[20:23], s49 offen offset:1024 nt lds
    s_waitcnt lgkmcnt(3)
    v_lshlrev_b32 v16, 16, v4
    v_and_b32 v17, 0xffff0000, v4
    v_lshlrev_b32 v18, 16, v5
    v_and_b32 v19, 0xffff0000, v5
    v_lshlrev_b32 v20, 16, v6
    v_and_b32 v21, 0xffff0000, v6
    v_lshlrev_b32 v22, 16, v7
    v_and_b32 v23, 0xffff0000, v7
    v_mul_f32 v16, 0x3e0293ee, v16
    v_mul_f32 v17, 0x3e0293ee, v17
    v_mul_f32 v18, 0x3e0293ee, v18
    v_mul_f32 v19, 0x3e0293ee, v19
    v_mul_f32 v20, 0x3e0293ee, v20
    v_mul_f32 v21, 0x3e0293ee, v21
    v_mul_f32 v22, 0x3e0293ee, v22
    v_mul_f32 v23, 0x3e0293ee, v23
    v_cvt_pk_bf16_f32 v4, v16, v17
    v_cvt_pk_bf16_f32 v5, v18, v19
    v_cvt_pk_bf16_f32 v6, v20, v21
    v_cvt_pk_bf16_f32 v7, v22, v23
    ds_write_b128 v202, v[4:7] offset:1024
    s_add_u32 m0, s48, 0x4000
    s_add_u32 s49, s46, 0x4000
    buffer_load_dwordx4 v196, s[16:19], s49 offen nt lds
    buffer_load_dwordx4 v197, s[16:19], s49 offen offset:1024 nt lds
    s_waitcnt lgkmcnt(3)
    v_lshlrev_b32 v16, 16, v8
    v_and_b32 v17, 0xffff0000, v8
    v_lshlrev_b32 v18, 16, v9
    v_and_b32 v19, 0xffff0000, v9
    v_lshlrev_b32 v20, 16, v10
    v_and_b32 v21, 0xffff0000, v10
    v_lshlrev_b32 v22, 16, v11
    v_and_b32 v23, 0xffff0000, v11
    v_mul_f32 v16, 0x3e0293ee, v16
    v_mul_f32 v17, 0x3e0293ee, v17
    v_mul_f32 v18, 0x3e0293ee, v18
    v_mul_f32 v19, 0x3e0293ee, v19
    v_mul_f32 v20, 0x3e0293ee, v20
    v_mul_f32 v21, 0x3e0293ee, v21
    v_mul_f32 v22, 0x3e0293ee, v22
    v_mul_f32 v23, 0x3e0293ee, v23
    v_cvt_pk_bf16_f32 v8, v16, v17
    v_cvt_pk_bf16_f32 v9, v18, v19
    v_cvt_pk_bf16_f32 v10, v20, v21
    v_cvt_pk_bf16_f32 v11, v22, v23
    ds_write_b128 v202, v[8:11] offset:8192
    s_add_u32 m0, s48, 0x6000
    s_add_u32 s49, s46, 0x4000
    buffer_load_dwordx4 v198, s[20:23], s49 offen nt lds
    buffer_load_dwordx4 v198, s[20:23], s49 offen offset:1024 nt lds
    s_waitcnt lgkmcnt(3)
    v_lshlrev_b32 v16, 16, v12
    v_and_b32 v17, 0xffff0000, v12
    v_lshlrev_b32 v18, 16, v13
    v_and_b32 v19, 0xffff0000, v13
    v_lshlrev_b32 v20, 16, v14
    v_and_b32 v21, 0xffff0000, v14
    v_lshlrev_b32 v22, 16, v15
    v_and_b32 v23, 0xffff0000, v15
    v_mul_f32 v16, 0x3e0293ee, v16
    v_mul_f32 v17, 0x3e0293ee, v17
    v_mul_f32 v18, 0x3e0293ee, v18
    v_mul_f32 v19, 0x3e0293ee, v19
    v_mul_f32 v20, 0x3e0293ee, v20
    v_mul_f32 v21, 0x3e0293ee, v21
    v_mul_f32 v22, 0x3e0293ee, v22
    v_mul_f32 v23, 0x3e0293ee, v23
    v_cvt_pk_bf16_f32 v12, v16, v17
    v_cvt_pk_bf16_f32 v13, v18, v19
    v_cvt_pk_bf16_f32 v14, v20, v21
    v_cvt_pk_bf16_f32 v15, v22, v23
    ds_write_b128 v202, v[12:15] offset:9216
    s_waitcnt lgkmcnt(0)
    s_cmp_eq_u32 s45, 0
    s_cbranch_scc1 L_g1start
    s_barrier
L_g1start:
    s_waitcnt vmcnt(7)
    s_barrier
    s_setprio 1
    ds_read_b128 v[64:67], v204
    ds_read_b128 v[96:99], v184 offset:0
    ds_read_b128 v[68:71], v205
    ds_read_b128 v[100:103], v185 offset:0
    ds_read_b128 v[72:75], v206
    ds_read_b128 v[104:107], v186 offset:0
    ds_read_b128 v[76:79], v207
    ds_read_b128 v[108:111], v187 offset:0
    ds_read_b128 v[80:83], v208
    ds_read_b128 v[112:115], v188 offset:0
    ds_read_b128 v[84:87], v209
    ds_read_b128 v[116:119], v189 offset:0
    ds_read_b128 v[88:91], v210
    ds_read_b128 v[120:123], v190 offset:0
    ds_read_b128 v[92:95], v211
    ds_read_b128 v[124:127], v191 offset:0
    s_waitcnt lgkmcnt(14)
    v_mfma_f32_32x32x16_bf16 v[160:175], v[96:99], v[64:67], 0
    s_waitcnt lgkmcnt(12)
    v_mfma_f32_32x32x16_bf16 v[160:175], v[100:103], v[68:71], v[160:175]
    s_waitcnt lgkmcnt(10)
    v_mfma_f32_32x32x16_bf16 v[160:175], v[104:107], v[72:75], v[160:175]
    s_waitcnt lgkmcnt(8)
    v_mfma_f32_32x32x16_bf16 v[160:175], v[108:111], v[76:79], v[160:175]
    s_waitcnt lgkmcnt(6)
    v_mfma_f32_32x32x16_bf16 v[160:175], v[112:115], v[80:83], v[160:175]
    s_waitcnt lgkmcnt(4)
    v_mfma_f32_32x32x16_bf16 v[160:175], v[116:119], v[84:87], v[160:175]
    s_waitcnt lgkmcnt(2)
    v_mfma_f32_32x32x16_bf16 v[160:175], v[120:123], v[88:91], v[160:175]
    s_waitcnt lgkmcnt(0)
    v_mfma_f32_32x32x16_bf16 v[160:175], v[124:127], v[92:95], v[160:175]
    s_waitcnt vmcnt(4)
    s_barrier
    s_setprio 0
    ds_read_b64_tr_b16 v[128:129], v192 offset:0
    ds_read_b64_tr_b16 v[130:131], v192 offset:2048
    ds_read_b64_tr_b16 v[132:133], v193 offset:0
    ds_read_b64_tr_b16 v[134:135], v193 offset:2048
    ds_read_b64_tr_b16 v[136:137], v194 offset:0
    ds_read_b64_tr_b16 v[138:139], v194 offset:2048
    ds_read_b64_tr_b16 v[140:141], v195 offset:0
    ds_read_b64_tr_b16 v[142:143], v195 offset:2048
    ds_read_b64_tr_b16 v[144:145], v192 offset:4096
    ds_read_b64_tr_b16 v[146:147], v192 offset:6144
    ds_read_b64_tr_b16 v[148:149], v193 offset:4096
    ds_read_b64_tr_b16 v[150:151], v193 offset:6144
    ds_read_b64_tr_b16 v[152:153], v194 offset:4096
    ds_read_b64_tr_b16 v[154:155], v194 offset:6144
    ds_read_b64_tr_b16 v[156:157], v195 offset:4096
    ds_read_b64_tr_b16 v[158:159], v195 offset:6144
    v_max3_f32 v203, v160, v161, v162
    v_max3_f32 v203, v203, v163, v164
    v_max3_f32 v203, v203, v165, v166
    v_max3_f32 v203, v203, v167, v168
    v_max3_f32 v203, v203, v169, v170
    v_max3_f32 v203, v203, v171, v172
    v_max3_f32 v203, v203, v173, v174
    v_max_f32 v203, v203, v175
    v_mov_b32 v204, v203
    s_nop 1
    v_permlane32_swap_b32 v204, v203
    v_max_f32 v203, v203, v204
    v_sub_f32 v200, 0xc0a00000, v203
    v_add_f32 v160, v160, v200
    v_add_f32 v161, v161, v200
    v_exp_f32 v160, v160
    v_add_f32 v162, v162, v200
    v_exp_f32 v161, v161
    v_add_f32 v163, v163, v200
    v_exp_f32 v162, v162
    v_add_f32 v164, v164, v200
    v_cvt_pk_bf16_f32 v176, v160, v161
    v_exp_f32 v163, v163
    v_add_f32 v165, v165, v200
    v_exp_f32 v164, v164
    v_add_f32 v166, v166, v200
    v_cvt_pk_bf16_f32 v177, v162, v163
    v_exp_f32 v165, v165
    v_add_f32 v167, v167, v200
    v_exp_f32 v166, v166
    v_add_f32 v168, v168, v200
    v_cvt_pk_bf16_f32 v178, v164, v165
    v_exp_f32 v167, v167
    v_add_f32 v169, v169, v200
    v_exp_f32 v168, v168
    v_add_f32 v170, v170, v200
    v_cvt_pk_bf16_f32 v179, v166, v167
    v_exp_f32 v169, v169
    v_add_f32 v171, v171, v200
    v_exp_f32 v170, v170
    v_add_f32 v172, v172, v200
    v_cvt_pk_bf16_f32 v180, v168, v169
    v_exp_f32 v171, v171
    v_add_f32 v173, v173, v200
    v_exp_f32 v172, v172
    v_add_f32 v174, v174, v200
    v_cvt_pk_bf16_f32 v181, v170, v171
    v_exp_f32 v173, v173
    v_add_f32 v175, v175, v200
    v_exp_f32 v174, v174
    v_cvt_pk_bf16_f32 v182, v172, v173
    v_exp_f32 v175, v175
    s_nop 0
    v_cvt_pk_bf16_f32 v183, v174, v175
    v_mov_b32 v232, v200
    v_mov_b32 v233, v200
    v_mov_b32 v234, v200
    v_mov_b32 v235, v200
    v_mov_b32 v236, v200
    v_mov_b32 v237, v200
    v_mov_b32 v238, v200
    v_mov_b32 v239, v200
    v_mov_b32 v240, v200
    v_mov_b32 v241, v200
    v_mov_b32 v242, v200
    v_mov_b32 v243, v200
    v_mov_b32 v244, v200
    v_mov_b32 v245, v200
    v_mov_b32 v246, v200
    v_mov_b32 v247, v200
    s_add_u32 m0, s48, 0x8000
    s_add_u32 s49, s46, 0x8000
    buffer_load_dwordx4 v196, s[16:19], s49 offen nt lds
    buffer_load_dwordx4 v197, s[16:19], s49 offen offset:1024 nt lds
    s_add_u32 m0, s48, 0xa000
    s_add_u32 s49, s46, 0x8000
    buffer_load_dwordx4 v198, s[20:23], s49 offen nt lds
    buffer_load_dwordx4 v198, s[20:23], s49 offen offset:1024 nt lds
    s_waitcnt vmcnt(4) lgkmcnt(0)
    s_barrier
    s_setprio 1
    v_mfma_f32_32x32x16_bf16 v[0:15], v[128:131], v[176:179], 0
    ds_read_b128 v[96:99], v184 offset:16384
    ds_read_b128 v[100:103], v185 offset:16384
    v_mfma_f32_32x32x16_bf16 v[16:31], v[132:135], v[176:179], 0
    ds_read_b128 v[104:107], v186 offset:16384
    ds_read_b128 v[108:111], v187 offset:16384
    v_mfma_f32_32x32x16_bf16 v[32:47], v[136:139], v[176:179], 0
    ds_read_b128 v[112:115], v188 offset:16384
    ds_read_b128 v[116:119], v189 offset:16384
    v_mfma_f32_32x32x16_bf16 v[48:63], v[140:143], v[176:179], 0
    ds_read_b128 v[120:123], v190 offset:16384
    ds_read_b128 v[124:127], v191 offset:16384
    v_mfma_f32_32x32x16_bf16 v[0:15], v[144:147], v[180:183], v[0:15]
    v_mfma_f32_16x16x32_bf16 v[248:251], v[252:255], v[176:179], 0
    v_mfma_f32_32x32x16_bf16 v[16:31], v[148:151], v[180:183], v[16:31]
    ds_read_b64_tr_b16 v[128:129], v192 offset:16384
    ds_read_b64_tr_b16 v[130:131], v192 offset:18432
    v_mfma_f32_32x32x16_bf16 v[32:47], v[152:155], v[180:183], v[32:47]
    v_mfma_f32_16x16x32_bf16 v[248:251], v[252:255], v[180:183], v[248:251]
    v_mfma_f32_32x32x16_bf16 v[48:63], v[156:159], v[180:183], v[48:63]
    ds_read_b64_tr_b16 v[132:133], v193 offset:16384
    ds_read_b64_tr_b16 v[134:135], v193 offset:18432
    s_waitcnt lgkmcnt(4)
    v_mfma_f32_32x32x16_bf16 v[160:175], v[96:99], v[64:67], v[232:247]
    ds_read_b64_tr_b16 v[136:137], v194 offset:16384
    ds_read_b64_tr_b16 v[138:139], v194 offset:18432
    v_mfma_f32_32x32x16_bf16 v[160:175], v[100:103], v[68:71], v[160:175]
    ds_read_b64_tr_b16 v[140:141], v195 offset:16384
    ds_read_b64_tr_b16 v[142:143], v195 offset:18432
    v_mfma_f32_32x32x16_bf16 v[160:175], v[104:107], v[72:75], v[160:175]
    ds_read_b64_tr_b16 v[144:145], v192 offset:20480
    ds_read_b64_tr_b16 v[146:147], v192 offset:22528
    v_mfma_f32_32x32x16_bf16 v[160:175], v[108:111], v[76:79], v[160:175]
    ds_read_b64_tr_b16 v[148:149], v193 offset:20480
    ds_read_b64_tr_b16 v[150:151], v193 offset:22528
    v_mfma_f32_32x32x16_bf16 v[160:175], v[112:115], v[80:83], v[160:175]
    ds_read_b64_tr_b16 v[152:153], v194 offset:20480
    ds_read_b64_tr_b16 v[154:155], v194 offset:22528
    v_mfma_f32_32x32x16_bf16 v[160:175], v[116:119], v[84:87], v[160:175]
    ds_read_b64_tr_b16 v[156:157], v195 offset:20480
    ds_read_b64_tr_b16 v[158:159], v195 offset:22528
    v_mfma_f32_32x32x16_bf16 v[160:175], v[120:123], v[88:91], v[160:175]
    v_mfma_f32_32x32x16_bf16 v[160:175], v[124:127], v[92:95], v[160:175]
    s_barrier
    s_setprio 0
    s_add_u32 m0, s48, 0xc000
    s_add_u32 s49, s46, 0xc000
    buffer_load_dwordx4 v196, s[16:19], s49 offen nt lds
    buffer_load_dwordx4 v197, s[16:19], s49 offen offset:1024 nt lds
    s_add_u32 m0, s48, 0xe000
    s_add_u32 s49, s46, 0xc000
    buffer_load_dwordx4 v198, s[20:23], s49 offen nt lds
    buffer_load_dwordx4 v198, s[20:23], s49 offen offset:1024 nt lds
    s_add_u32 m0, s48, 0x0
    s_add_u32 s49, s46, 0x10000
    buffer_load_dwordx4 v196, s[16:19], s49 offen nt lds
    buffer_load_dwordx4 v197, s[16:19], s49 offen offset:1024 nt lds
    s_add_u32 m0, s48, 0x2000
    s_add_u32 s49, s46, 0x10000
    buffer_load_dwordx4 v198, s[20:23], s49 offen nt lds
    buffer_load_dwordx4 v198, s[20:23], s49 offen offset:1024 nt lds
    v_exp_f32 v160, v160
    v_exp_f32 v161, v161
    v_exp_f32 v162, v162
    v_cvt_pk_bf16_f32 v176, v160, v161
    v_exp_f32 v163, v163
    v_exp_f32 v164, v164
    v_cvt_pk_bf16_f32 v177, v162, v163
    v_exp_f32 v165, v165
    v_exp_f32 v166, v166
    v_cvt_pk_bf16_f32 v178, v164, v165
    v_exp_f32 v167, v167
    v_exp_f32 v168, v168
    v_cvt_pk_bf16_f32 v179, v166, v167
    v_exp_f32 v169, v169
    v_or3_b32 v203, v176, v177, v178
    v_exp_f32 v170, v170
    v_cvt_pk_bf16_f32 v180, v168, v169
    v_exp_f32 v171, v171
    v_exp_f32 v172, v172
    v_cvt_pk_bf16_f32 v181, v170, v171
    v_exp_f32 v173, v173
    v_or3_b32 v203, v203, v179, v180
    v_exp_f32 v174, v174
    v_cvt_pk_bf16_f32 v182, v172, v173
    v_exp_f32 v175, v175
    v_or3_b32 v203, v203, v181, v182
    v_cvt_pk_bf16_f32 v183, v174, v175
    v_or_b32 v203, v203, v183
    v_and_b32 v203, 0x40004000, v203
    v_cmp_ne_u32 vcc, 0, v203
    s_cbranch_vccz L_nors1
    s_call_b64 s[58:59], L_rescale
L_nors1:
    s_waitcnt vmcnt(18)
    v_and_b32 v220, 1, v220
    v_cmp_eq_u32 vcc, 0, v220
    v_lshlrev_b32 v221, 2, s51
    s_nop 0
    s_or_b32 s53, vcc_lo, 0x88442211
    v_mov_b32 v220, s53
    s_mov_b64 exec, 1
    buffer_store_dword v220, v221, s[36:39], s3 offen sc1
    s_mov_b64 exec, -1
    s_waitcnt vmcnt(9) lgkmcnt(0)
    s_barrier
    s_setprio 1
    v_mfma_f32_32x32x16_bf16 v[0:15], v[128:131], v[176:179], v[0:15]
    ds_read_b128 v[96:99], v184 offset:32768
    ds_read_b128 v[100:103], v185 offset:32768
    v_mfma_f32_32x32x16_bf16 v[16:31], v[132:135], v[176:179], v[16:31]
    ds_read_b128 v[104:107], v186 offset:32768
    ds_read_b128 v[108:111], v187 offset:32768
    v_mfma_f32_32x32x16_bf16 v[32:47], v[136:139], v[176:179], v[32:47]
    ds_read_b128 v[112:115], v188 offset:32768
    ds_read_b128 v[116:119], v189 offset:32768
    v_mfma_f32_32x32x16_bf16 v[48:63], v[140:143], v[176:179], v[48:63]
    ds_read_b128 v[120:123], v190 offset:32768
    ds_read_b128 v[124:127], v191 offset:32768
    v_mfma_f32_32x32x16_bf16 v[0:15], v[144:147], v[180:183], v[0:15]
    v_mfma_f32_16x16x32_bf16 v[248:251], v[252:255], v[176:179], v[248:251]
    v_mfma_f32_32x32x16_bf16 v[16:31], v[148:151], v[180:183], v[16:31]
    ds_read_b64_tr_b16 v[128:129], v192 offset:32768
    ds_read_b64_tr_b16 v[130:131], v192 offset:34816
    v_mfma_f32_32x32x16_bf16 v[32:47], v[152:155], v[180:183], v[32:47]
    v_mfma_f32_16x16x32_bf16 v[248:251], v[252:255], v[180:183], v[248:251]
    v_mfma_f32_32x32x16_bf16 v[48:63], v[156:159], v[180:183], v[48:63]
    ds_read_b64_tr_b16 v[132:133], v193 offset:32768
    ds_read_b64_tr_b16 v[134:135], v193 offset:34816
    s_waitcnt lgkmcnt(4)
    v_mfma_f32_32x32x16_bf16 v[160:175], v[96:99], v[64:67], v[232:247]
    ds_read_b64_tr_b16 v[136:137], v194 offset:32768
    ds_read_b64_tr_b16 v[138:139], v194 offset:34816
    v_mfma_f32_32x32x16_bf16 v[160:175], v[100:103], v[68:71], v[160:175]
    ds_read_b64_tr_b16 v[140:141], v195 offset:32768
    ds_read_b64_tr_b16 v[142:143], v195 offset:34816
    v_mfma_f32_32x32x16_bf16 v[160:175], v[104:107], v[72:75], v[160:175]
    ds_read_b64_tr_b16 v[144:145], v192 offset:36864
    ds_read_b64_tr_b16 v[146:147], v192 offset:38912
    v_mfma_f32_32x32x16_bf16 v[160:175], v[108:111], v[76:79], v[160:175]
    ds_read_b64_tr_b16 v[148:149], v193 offset:36864
    ds_read_b64_tr_b16 v[150:151], v193 offset:38912
    v_mfma_f32_32x32x16_bf16 v[160:175], v[112:115], v[80:83], v[160:175]
    ds_read_b64_tr_b16 v[152:153], v194 offset:36864
    ds_read_b64_tr_b16 v[154:155], v194 offset:38912
    v_mfma_f32_32x32x16_bf16 v[160:175], v[116:119], v[84:87], v[160:175]
    ds_read_b64_tr_b16 v[156:157], v195 offset:36864
    ds_read_b64_tr_b16 v[158:159], v195 offset:38912
    v_mfma_f32_32x32x16_bf16 v[160:175], v[120:123], v[88:91], v[160:175]
    v_mfma_f32_32x32x16_bf16 v[160:175], v[124:127], v[92:95], v[160:175]
    s_barrier
    s_setprio 0
    s_add_u32 m0, s48, 0x4000
    s_add_u32 s49, s46, 0x14000
    buffer_load_dwordx4 v196, s[16:19], s49 offen nt lds
    buffer_load_dwordx4 v197, s[16:19], s49 offen offset:1024 nt lds
    s_add_u32 m0, s48, 0x6000
    s_add_u32 s49, s46, 0x14000
    buffer_load_dwordx4 v198, s[20:23], s49 offen nt lds
    buffer_load_dwordx4 v198, s[20:23], s49 offen offset:1024 nt lds
    s_add_u32 m0, s48, 0x8000
    s_add_u32 s49, s46, 0x18000
    buffer_load_dwordx4 v196, s[16:19], s49 offen nt lds
    buffer_load_dwordx4 v197, s[16:19], s49 offen offset:1024 nt lds
    v_exp_f32 v160, v160
    v_exp_f32 v161, v161
    v_exp_f32 v162, v162
    v_cvt_pk_bf16_f32 v176, v160, v161
    v_exp_f32 v163, v163
    v_exp_f32 v164, v164
    v_cvt_pk_bf16_f32 v177, v162, v163
    v_exp_f32 v165, v165
    v_exp_f32 v166, v166
    v_cvt_pk_bf16_f32 v178, v164, v165
    v_exp_f32 v167, v167
    v_exp_f32 v168, v168
    v_cvt_pk_bf16_f32 v179, v166, v167
    v_exp_f32 v169, v169
    v_or3_b32 v203, v176, v177, v178
    v_exp_f32 v170, v170
    v_cvt_pk_bf16_f32 v180, v168, v169
    v_exp_f32 v171, v171
    v_exp_f32 v172, v172
    v_cvt_pk_bf16_f32 v181, v170, v171
    v_exp_f32 v173, v173
    v_or3_b32 v203, v203, v179, v180
    v_exp_f32 v174, v174
    v_cvt_pk_bf16_f32 v182, v172, v173
    v_exp_f32 v175, v175
    v_or3_b32 v203, v203, v181, v182
    v_cvt_pk_bf16_f32 v183, v174, v175
    v_or_b32 v203, v203, v183
    v_and_b32 v203, 0x40004000, v203
    v_cmp_ne_u32 vcc, 0, v203
    s_cbranch_vccz L_nors2
    s_call_b64 s[58:59], L_rescale
L_nors2:
    buffer_store_dwordx2 v[216:217], v224, s[32:35], s97 offen sc1
    s_waitcnt vmcnt(12) lgkmcnt(0)
    s_barrier
    s_setprio 1
    v_mfma_f32_32x32x16_bf16 v[0:15], v[128:131], v[176:179], v[0:15]
    ds_read_b128 v[96:99], v184 offset:49152
    ds_read_b128 v[100:103], v185 offset:49152
    v_mfma_f32_32x32x16_bf16 v[16:31], v[132:135], v[176:179], v[16:31]
    ds_read_b128 v[104:107], v186 offset:49152
    ds_read_b128 v[108:111], v187 offset:49152
    v_mfma_f32_32x32x16_bf16 v[32:47], v[136:139], v[176:179], v[32:47]
    ds_read_b128 v[112:115], v188 offset:49152
    ds_read_b128 v[116:119], v189 offset:49152
    v_mfma_f32_32x32x16_bf16 v[48:63], v[140:143], v[176:179], v[48:63]
    ds_read_b128 v[120:123], v190 offset:49152
    ds_read_b128 v[124:127], v191 offset:49152
    v_mfma_f32_32x32x16_bf16 v[0:15], v[144:147], v[180:183], v[0:15]
    v_mfma_f32_16x16x32_bf16 v[248:251], v[252:255], v[176:179], v[248:251]
    v_mfma_f32_32x32x16_bf16 v[16:31], v[148:151], v[180:183], v[16:31]
    ds_read_b64_tr_b16 v[128:129], v192 offset:49152
    ds_read_b64_tr_b16 v[130:131], v192 offset:51200
    v_mfma_f32_32x32x16_bf16 v[32:47], v[152:155], v[180:183], v[32:47]
    v_mfma_f32_16x16x32_bf16 v[248:251], v[252:255], v[180:183], v[248:251]
    v_mfma_f32_32x32x16_bf16 v[48:63], v[156:159], v[180:183], v[48:63]
    ds_read_b64_tr_b16 v[132:133], v193 offset:49152
    ds_read_b64_tr_b16 v[134:135], v193 offset:51200
    s_waitcnt lgkmcnt(4)
    v_mfma_f32_32x32x16_bf16 v[160:175], v[96:99], v[64:67], v[232:247]
    ds_read_b64_tr_b16 v[136:137], v194 offset:49152
    ds_read_b64_tr_b16 v[138:139], v194 offset:51200
    v_mfma_f32_32x32x16_bf16 v[160:175], v[100:103], v[68:71], v[160:175]
    ds_read_b64_tr_b16 v[140:141], v195 offset:49152
    ds_read_b64_tr_b16 v[142:143], v195 offset:51200
    v_mfma_f32_32x32x16_bf16 v[160:175], v[104:107], v[72:75], v[160:175]
    ds_read_b64_tr_b16 v[144:145], v192 offset:53248
    ds_read_b64_tr_b16 v[146:147], v192 offset:55296
    v_mfma_f32_32x32x16_bf16 v[160:175], v[108:111], v[76:79], v[160:175]
    ds_read_b64_tr_b16 v[148:149], v193 offset:53248
    ds_read_b64_tr_b16 v[150:151], v193 offset:55296
    v_mfma_f32_32x32x16_bf16 v[160:175], v[112:115], v[80:83], v[160:175]
    ds_read_b64_tr_b16 v[152:153], v194 offset:53248
    ds_read_b64_tr_b16 v[154:155], v194 offset:55296
    v_mfma_f32_32x32x16_bf16 v[160:175], v[116:119], v[84:87], v[160:175]
    ds_read_b64_tr_b16 v[156:157], v195 offset:53248
    ds_read_b64_tr_b16 v[158:159], v195 offset:55296
    v_mfma_f32_32x32x16_bf16 v[160:175], v[120:123], v[88:91], v[160:175]
    v_mfma_f32_32x32x16_bf16 v[160:175], v[124:127], v[92:95], v[160:175]
    s_barrier
    s_setprio 0
    s_add_u32 m0, s48, 0xa000
    s_add_u32 s49, s46, 0x18000
    buffer_load_dwordx4 v198, s[20:23], s49 offen nt lds
    buffer_load_dwordx4 v198, s[20:23], s49 offen offset:1024 nt lds
    s_add_u32 m0, s48, 0xc000
    s_add_u32 s49, s46, 0x1c000
    buffer_load_dwordx4 v196, s[16:19], s49 offen nt lds
    buffer_load_dwordx4 v197, s[16:19], s49 offen offset:1024 nt lds
    s_nop 1
    v_exp_f32 v160, v160
    v_exp_f32 v161, v161
    v_exp_f32 v162, v162
    v_cvt_pk_bf16_f32 v176, v160, v161
    v_exp_f32 v163, v163
    v_exp_f32 v164, v164
    v_cvt_pk_bf16_f32 v177, v162, v163
    v_exp_f32 v165, v165
    v_exp_f32 v166, v166
    v_cvt_pk_bf16_f32 v178, v164, v165
    v_exp_f32 v167, v167
    v_exp_f32 v168, v168
    v_cvt_pk_bf16_f32 v179, v166, v167
    v_exp_f32 v169, v169
    v_or3_b32 v203, v176, v177, v178
    v_exp_f32 v170, v170
    v_cvt_pk_bf16_f32 v180, v168, v169
    v_exp_f32 v171, v171
    v_exp_f32 v172, v172
    v_cvt_pk_bf16_f32 v181, v170, v171
    v_exp_f32 v173, v173
    v_or3_b32 v203, v203, v179, v180
    v_exp_f32 v174, v174
    v_cvt_pk_bf16_f32 v182, v172, v173
    v_exp_f32 v175, v175
    v_or3_b32 v203, v203, v181, v182
    v_cvt_pk_bf16_f32 v183, v174, v175
    v_or_b32 v203, v203, v183
    v_and_b32 v203, 0x40004000, v203
    v_cmp_ne_u32 vcc, 0, v203
    s_cbranch_vccz L_nors3
    s_call_b64 s[58:59], L_rescale
L_nors3:
    buffer_store_dwordx4 v[216:219], v223, s[32:35], s95 offen offset:0 sc1
    s_waitcnt vmcnt(13) lgkmcnt(0)
    s_barrier
    s_setprio 1
    v_mfma_f32_32x32x16_bf16 v[0:15], v[128:131], v[176:179], v[0:15]
    ds_read_b128 v[96:99], v184 offset:0
    ds_read_b128 v[100:103], v185 offset:0
    v_mfma_f32_32x32x16_bf16 v[16:31], v[132:135], v[176:179], v[16:31]
    ds_read_b128 v[104:107], v186 offset:0
    ds_read_b128 v[108:111], v187 offset:0
    v_mfma_f32_32x32x16_bf16 v[32:47], v[136:139], v[176:179], v[32:47]
    ds_read_b128 v[112:115], v188 offset:0
    ds_read_b128 v[116:119], v189 offset:0
    v_mfma_f32_32x32x16_bf16 v[48:63], v[140:143], v[176:179], v[48:63]
    ds_read_b128 v[120:123], v190 offset:0
    ds_read_b128 v[124:127], v191 offset:0
    v_mfma_f32_32x32x16_bf16 v[0:15], v[144:147], v[180:183], v[0:15]
    v_mfma_f32_16x16x32_bf16 v[248:251], v[252:255], v[176:179], v[248:251]
    v_mfma_f32_32x32x16_bf16 v[16:31], v[148:151], v[180:183], v[16:31]
    ds_read_b64_tr_b16 v[128:129], v192 offset:0
    ds_read_b64_tr_b16 v[130:131], v192 offset:2048
    v_mfma_f32_32x32x16_bf16 v[32:47], v[152:155], v[180:183], v[32:47]
    v_mfma_f32_16x16x32_bf16 v[248:251], v[252:255], v[180:183], v[248:251]
    v_mfma_f32_32x32x16_bf16 v[48:63], v[156:159], v[180:183], v[48:63]
    ds_read_b64_tr_b16 v[132:133], v193 offset:0
    ds_read_b64_tr_b16 v[134:135], v193 offset:2048
    s_waitcnt lgkmcnt(4)
    v_mfma_f32_32x32x16_bf16 v[160:175], v[96:99], v[64:67], v[232:247]
    ds_read_b64_tr_b16 v[136:137], v194 offset:0
    ds_read_b64_tr_b16 v[138:139], v194 offset:2048
    v_mfma_f32_32x32x16_bf16 v[160:175], v[100:103], v[68:71], v[160:175]
    ds_read_b64_tr_b16 v[140:141], v195 offset:0
    ds_read_b64_tr_b16 v[142:143], v195 offset:2048
    v_mfma_f32_32x32x16_bf16 v[160:175], v[104:107], v[72:75], v[160:175]
    ds_read_b64_tr_b16 v[144:145], v192 offset:4096
    ds_read_b64_tr_b16 v[146:147], v192 offset:6144
    v_mfma_f32_32x32x16_bf16 v[160:175], v[108:111], v[76:79], v[160:175]
    ds_read_b64_tr_b16 v[148:149], v193 offset:4096
    ds_read_b64_tr_b16 v[150:151], v193 offset:6144
    v_mfma_f32_32x32x16_bf16 v[160:175], v[112:115], v[80:83], v[160:175]
    ds_read_b64_tr_b16 v[152:153], v194 offset:4096
    ds_read_b64_tr_b16 v[154:155], v194 offset:6144
    v_mfma_f32_32x32x16_bf16 v[160:175], v[116:119], v[84:87], v[160:175]
    ds_read_b64_tr_b16 v[156:157], v195 offset:4096
    ds_read_b64_tr_b16 v[158:159], v195 offset:6144
    v_mfma_f32_32x32x16_bf16 v[160:175], v[120:123], v[88:91], v[160:175]
    v_mfma_f32_32x32x16_bf16 v[160:175], v[124:127], v[92:95], v[160:175]
    s_barrier
    s_setprio 0
    s_add_u32 m0, s48, 0xe000
    s_add_u32 s49, s46, 0x1c000
    buffer_load_dwordx4 v198, s[20:23], s49 offen nt lds
    buffer_load_dwordx4 v198, s[20:23], s49 offen offset:1024 nt lds
    s_nop 5
    v_exp_f32 v160, v160
    v_exp_f32 v161, v161
    v_exp_f32 v162, v162
    v_cvt_pk_bf16_f32 v176, v160, v161
    v_exp_f32 v163, v163
    v_exp_f32 v164, v164
    v_cvt_pk_bf16_f32 v177, v162, v163
    v_exp_f32 v165, v165
    v_exp_f32 v166, v166
    v_cvt_pk_bf16_f32 v178, v164, v165
    v_exp_f32 v167, v167
    v_exp_f32 v168, v168
    v_cvt_pk_bf16_f32 v179, v166, v167
    v_exp_f32 v169, v169
    v_or3_b32 v203, v176, v177, v178
    v_exp_f32 v170, v170
    v_cvt_pk_bf16_f32 v180, v168, v169
    v_exp_f32 v171, v171
    v_exp_f32 v172, v172
    v_cvt_pk_bf16_f32 v181, v170, v171
    v_exp_f32 v173, v173
    v_or3_b32 v203, v203, v179, v180
    v_exp_f32 v174, v174
    v_cvt_pk_bf16_f32 v182, v172, v173
    v_exp_f32 v175, v175
    v_or3_b32 v203, v203, v181, v182
    v_cvt_pk_bf16_f32 v183, v174, v175
    v_or_b32 v203, v203, v183
    v_and_b32 v203, 0x40004000, v203
    v_cmp_ne_u32 vcc, 0, v203
    s_cbranch_vccz L_nors4
    s_call_b64 s[58:59], L_rescale
L_nors4:
    buffer_store_dwordx4 v[216:219], v223, s[32:35], s95 offen offset:1024 sc1
    v_lshlrev_b32 v222, 2, s51
    s_mov_b64 exec, 1
    buffer_load_dword v222, v222, s[36:39], s57 offen sc1
    s_mov_b64 exec, -1
    s_waitcnt vmcnt(12) lgkmcnt(0)
    s_barrier
    s_setprio 1
    v_mfma_f32_32x32x16_bf16 v[0:15], v[128:131], v[176:179], v[0:15]
    ds_read_b128 v[96:99], v184 offset:16384
    ds_read_b128 v[100:103], v185 offset:16384
    v_mfma_f32_32x32x16_bf16 v[16:31], v[132:135], v[176:179], v[16:31]
    ds_read_b128 v[104:107], v186 offset:16384
    ds_read_b128 v[108:111], v187 offset:16384
    v_mfma_f32_32x32x16_bf16 v[32:47], v[136:139], v[176:179], v[32:47]
    ds_read_b128 v[112:115], v188 offset:16384
    ds_read_b128 v[116:119], v189 offset:16384
    v_mfma_f32_32x32x16_bf16 v[48:63], v[140:143], v[176:179], v[48:63]
    ds_read_b128 v[120:123], v190 offset:16384
    ds_read_b128 v[124:127], v191 offset:16384
    v_mfma_f32_32x32x16_bf16 v[0:15], v[144:147], v[180:183], v[0:15]
    v_mfma_f32_16x16x32_bf16 v[248:251], v[252:255], v[176:179], v[248:251]
    v_mfma_f32_32x32x16_bf16 v[16:31], v[148:151], v[180:183], v[16:31]
    ds_read_b64_tr_b16 v[128:129], v192 offset:16384
    ds_read_b64_tr_b16 v[130:131], v192 offset:18432
    v_mfma_f32_32x32x16_bf16 v[32:47], v[152:155], v[180:183], v[32:47]
    v_mfma_f32_16x16x32_bf16 v[248:251], v[252:255], v[180:183], v[248:251]
    v_mfma_f32_32x32x16_bf16 v[48:63], v[156:159], v[180:183], v[48:63]
    ds_read_b64_tr_b16 v[132:133], v193 offset:16384
    ds_read_b64_tr_b16 v[134:135], v193 offset:18432
    s_waitcnt lgkmcnt(4)
    v_mfma_f32_32x32x16_bf16 v[160:175], v[96:99], v[64:67], v[232:247]
    ds_read_b64_tr_b16 v[136:137], v194 offset:16384
    ds_read_b64_tr_b16 v[138:139], v194 offset:18432
    v_mfma_f32_32x32x16_bf16 v[160:175], v[100:103], v[68:71], v[160:175]
    ds_read_b64_tr_b16 v[140:141], v195 offset:16384
    ds_read_b64_tr_b16 v[142:143], v195 offset:18432
    v_mfma_f32_32x32x16_bf16 v[160:175], v[104:107], v[72:75], v[160:175]
    ds_read_b64_tr_b16 v[144:145], v192 offset:20480
    ds_read_b64_tr_b16 v[146:147], v192 offset:22528
    v_mfma_f32_32x32x16_bf16 v[160:175], v[108:111], v[76:79], v[160:175]
    ds_read_b64_tr_b16 v[148:149], v193 offset:20480
    ds_read_b64_tr_b16 v[150:151], v193 offset:22528
    v_mfma_f32_32x32x16_bf16 v[160:175], v[112:115], v[80:83], v[160:175]
    ds_read_b64_tr_b16 v[152:153], v194 offset:20480
    ds_read_b64_tr_b16 v[154:155], v194 offset:22528
    v_mfma_f32_32x32x16_bf16 v[160:175], v[116:119], v[84:87], v[160:175]
    ds_read_b64_tr_b16 v[156:157], v195 offset:20480
    ds_read_b64_tr_b16 v[158:159], v195 offset:22528
    v_mfma_f32_32x32x16_bf16 v[160:175], v[120:123], v[88:91], v[160:175]
    v_mfma_f32_32x32x16_bf16 v[160:175], v[124:127], v[92:95], v[160:175]
    s_barrier
    s_setprio 0
    s_nop 9
    v_exp_f32 v160, v160
    v_exp_f32 v161, v161
    v_exp_f32 v162, v162
    v_cvt_pk_bf16_f32 v176, v160, v161
    v_exp_f32 v163, v163
    v_exp_f32 v164, v164
    v_cvt_pk_bf16_f32 v177, v162, v163
    v_exp_f32 v165, v165
    v_exp_f32 v166, v166
    v_cvt_pk_bf16_f32 v178, v164, v165
    v_exp_f32 v167, v167
    v_exp_f32 v168, v168
    v_cvt_pk_bf16_f32 v179, v166, v167
    v_exp_f32 v169, v169
    v_or3_b32 v203, v176, v177, v178
    v_exp_f32 v170, v170
    v_cvt_pk_bf16_f32 v180, v168, v169
    v_exp_f32 v171, v171
    v_exp_f32 v172, v172
    v_cvt_pk_bf16_f32 v181, v170, v171
    v_exp_f32 v173, v173
    v_or3_b32 v203, v203, v179, v180
    v_exp_f32 v174, v174
    v_cvt_pk_bf16_f32 v182, v172, v173
    v_exp_f32 v175, v175
    v_or3_b32 v203, v203, v181, v182
    v_cvt_pk_bf16_f32 v183, v174, v175
    v_or_b32 v203, v203, v183
    v_and_b32 v203, 0x40004000, v203
    v_cmp_ne_u32 vcc, 0, v203
    s_cbranch_vccz L_nors5
    s_call_b64 s[58:59], L_rescale
L_nors5:
    buffer_store_dwordx4 v[216:219], v223, s[32:35], s95 offen offset:2048 sc1
    s_waitcnt vmcnt(8) lgkmcnt(0)
    s_barrier
    s_setprio 1
    v_mfma_f32_32x32x16_bf16 v[0:15], v[128:131], v[176:179], v[0:15]
    ds_read_b128 v[96:99], v184 offset:32768
    ds_read_b128 v[100:103], v185 offset:32768
    v_mfma_f32_32x32x16_bf16 v[16:31], v[132:135], v[176:179], v[16:31]
    ds_read_b128 v[104:107], v186 offset:32768
    ds_read_b128 v[108:111], v187 offset:32768
    v_mfma_f32_32x32x16_bf16 v[32:47], v[136:139], v[176:179], v[32:47]
    ds_read_b128 v[112:115], v188 offset:32768
    ds_read_b128 v[116:119], v189 offset:32768
    v_mfma_f32_32x32x16_bf16 v[48:63], v[140:143], v[176:179], v[48:63]
    ds_read_b128 v[120:123], v190 offset:32768
    ds_read_b128 v[124:127], v191 offset:32768
    v_mfma_f32_32x32x16_bf16 v[0:15], v[144:147], v[180:183], v[0:15]
    v_mfma_f32_16x16x32_bf16 v[248:251], v[252:255], v[176:179], v[248:251]
    v_mfma_f32_32x32x16_bf16 v[16:31], v[148:151], v[180:183], v[16:31]
    ds_read_b64_tr_b16 v[128:129], v192 offset:32768
    ds_read_b64_tr_b16 v[130:131], v192 offset:34816
    v_mfma_f32_32x32x16_bf16 v[32:47], v[152:155], v[180:183], v[32:47]
    v_mfma_f32_16x16x32_bf16 v[248:251], v[252:255], v[180:183], v[248:251]
    v_mfma_f32_32x32x16_bf16 v[48:63], v[156:159], v[180:183], v[48:63]
    ds_read_b64_tr_b16 v[132:133], v193 offset:32768
    ds_read_b64_tr_b16 v[134:135], v193 offset:34816
    s_waitcnt lgkmcnt(4)
    v_mfma_f32_32x32x16_bf16 v[160:175], v[96:99], v[64:67], v[232:247]
    ds_read_b64_tr_b16 v[136:137], v194 offset:32768
    ds_read_b64_tr_b16 v[138:139], v194 offset:34816
    v_mfma_f32_32x32x16_bf16 v[160:175], v[100:103], v[68:71], v[160:175]
    ds_read_b64_tr_b16 v[140:141], v195 offset:32768
    ds_read_b64_tr_b16 v[142:143], v195 offset:34816
    v_mfma_f32_32x32x16_bf16 v[160:175], v[104:107], v[72:75], v[160:175]
    ds_read_b64_tr_b16 v[144:145], v192 offset:36864
    ds_read_b64_tr_b16 v[146:147], v192 offset:38912
    v_mfma_f32_32x32x16_bf16 v[160:175], v[108:111], v[76:79], v[160:175]
    ds_read_b64_tr_b16 v[148:149], v193 offset:36864
    ds_read_b64_tr_b16 v[150:151], v193 offset:38912
    v_mfma_f32_32x32x16_bf16 v[160:175], v[112:115], v[80:83], v[160:175]
    ds_read_b64_tr_b16 v[152:153], v194 offset:36864
    ds_read_b64_tr_b16 v[154:155], v194 offset:38912
    v_mfma_f32_32x32x16_bf16 v[160:175], v[116:119], v[84:87], v[160:175]
    ds_read_b64_tr_b16 v[156:157], v195 offset:36864
    ds_read_b64_tr_b16 v[158:159], v195 offset:38912
    v_mfma_f32_32x32x16_bf16 v[160:175], v[120:123], v[88:91], v[160:175]
    v_mfma_f32_32x32x16_bf16 v[160:175], v[124:127], v[92:95], v[160:175]
    s_barrier
    s_setprio 0
    s_nop 9
    v_exp_f32 v160, v160
    v_exp_f32 v161, v161
    v_exp_f32 v162, v162
    v_cvt_pk_bf16_f32 v176, v160, v161
    v_exp_f32 v163, v163
    v_exp_f32 v164, v164
    v_cvt_pk_bf16_f32 v177, v162, v163
    v_exp_f32 v165, v165
    v_exp_f32 v166, v166
    v_cvt_pk_bf16_f32 v178, v164, v165
    v_exp_f32 v167, v167
    v_exp_f32 v168, v168
    v_cvt_pk_bf16_f32 v179, v166, v167
    v_exp_f32 v169, v169
    v_or3_b32 v203, v176, v177, v178
    v_exp_f32 v170, v170
    v_cvt_pk_bf16_f32 v180, v168, v169
    v_exp_f32 v171, v171
    v_exp_f32 v172, v172
    v_cvt_pk_bf16_f32 v181, v170, v171
    v_exp_f32 v173, v173
    v_or3_b32 v203, v203, v179, v180
    v_exp_f32 v174, v174
    v_cvt_pk_bf16_f32 v182, v172, v173
    v_exp_f32 v175, v175
    v_or3_b32 v203, v203, v181, v182
    v_cvt_pk_bf16_f32 v183, v174, v175
    v_or_b32 v203, v203, v183
    v_and_b32 v203, 0x40004000, v203
    v_cmp_ne_u32 vcc, 0, v203
    s_cbranch_vccz L_nors6
    s_call_b64 s[58:59], L_rescale
L_nors6:
    buffer_store_dwordx4 v[216:219], v223, s[32:35], s95 offen offset:3072 sc1
    s_waitcnt vmcnt(2)
    s_cmp_lg_u32 s40, 0
    s_cbranch_scc1 L_dbgdone
    s_mov_b32 s56, 0
L_dbgpoll:
    v_readfirstlane_b32 s53, v222
    s_nop 1
    s_and_b32 s54, s53, 0x08040201
    s_cmp_eq_u32 s54, 0x08040201
    s_cbranch_scc1 L_dbgok
    s_add_u32 s56, s56, 1
    s_cmp_gt_u32 s56, 0x40000
    s_cbranch_scc1 L_dbgok
    s_sleep 2
    v_lshlrev_b32 v222, 2, s51
    s_mov_b64 exec, 1
    buffer_load_dword v222, v222, s[36:39], 0 offen sc1
    s_mov_b64 exec, -1
    s_waitcnt vmcnt(0)
    s_branch L_dbgpoll
L_dbgok:
    v_mov_b32 v221, 0x8000
    s_mov_b64 exec, 1
    ds_write_b32 v221, v222
    s_mov_b64 exec, -1
L_dbgdone:
    s_waitcnt vmcnt(4) lgkmcnt(0)
    s_barrier
    s_setprio 1
    v_mfma_f32_32x32x16_bf16 v[0:15], v[128:131], v[176:179], v[0:15]
    ds_read_b128 v[96:99], v184 offset:49152
    ds_read_b128 v[100:103], v185 offset:49152
    v_mfma_f32_32x32x16_bf16 v[16:31], v[132:135], v[176:179], v[16:31]
    ds_read_b128 v[104:107], v186 offset:49152
    ds_read_b128 v[108:111], v187 offset:49152
    v_mfma_f32_32x32x16_bf16 v[32:47], v[136:139], v[176:179], v[32:47]
    ds_read_b128 v[112:115], v188 offset:49152
    ds_read_b128 v[116:119], v189 offset:49152
    v_mfma_f32_32x32x16_bf16 v[48:63], v[140:143], v[176:179], v[48:63]
    ds_read_b128 v[120:123], v190 offset:49152
    ds_read_b128 v[124:127], v191 offset:49152
    v_mfma_f32_32x32x16_bf16 v[0:15], v[144:147], v[180:183], v[0:15]
    v_mfma_f32_16x16x32_bf16 v[248:251], v[252:255], v[176:179], v[248:251]
    v_mfma_f32_32x32x16_bf16 v[16:31], v[148:151], v[180:183], v[16:31]
    ds_read_b64_tr_b16 v[128:129], v192 offset:49152
    ds_read_b64_tr_b16 v[130:131], v192 offset:51200
    v_mfma_f32_32x32x16_bf16 v[32:47], v[152:155], v[180:183], v[32:47]
    v_mfma_f32_16x16x32_bf16 v[248:251], v[252:255], v[180:183], v[248:251]
    v_mfma_f32_32x32x16_bf16 v[48:63], v[156:159], v[180:183], v[48:63]
    ds_read_b64_tr_b16 v[132:133], v193 offset:49152
    ds_read_b64_tr_b16 v[134:135], v193 offset:51200
    s_waitcnt lgkmcnt(4)
    v_mfma_f32_32x32x16_bf16 v[160:175], v[96:99], v[64:67], v[232:247]
    ds_read_b64_tr_b16 v[136:137], v194 offset:49152
    ds_read_b64_tr_b16 v[138:139], v194 offset:51200
    v_mfma_f32_32x32x16_bf16 v[160:175], v[100:103], v[68:71], v[160:175]
    ds_read_b64_tr_b16 v[140:141], v195 offset:49152
    ds_read_b64_tr_b16 v[142:143], v195 offset:51200
    v_mfma_f32_32x32x16_bf16 v[160:175], v[104:107], v[72:75], v[160:175]
    ds_read_b64_tr_b16 v[144:145], v192 offset:53248
    ds_read_b64_tr_b16 v[146:147], v192 offset:55296
    v_mfma_f32_32x32x16_bf16 v[160:175], v[108:111], v[76:79], v[160:175]
    ds_read_b64_tr_b16 v[148:149], v193 offset:53248
    ds_read_b64_tr_b16 v[150:151], v193 offset:55296
    v_mfma_f32_32x32x16_bf16 v[160:175], v[112:115], v[80:83], v[160:175]
    ds_read_b64_tr_b16 v[152:153], v194 offset:53248
    ds_read_b64_tr_b16 v[154:155], v194 offset:55296
    v_mfma_f32_32x32x16_bf16 v[160:175], v[116:119], v[84:87], v[160:175]
    ds_read_b64_tr_b16 v[156:157], v195 offset:53248
    ds_read_b64_tr_b16 v[158:159], v195 offset:55296
    v_mfma_f32_32x32x16_bf16 v[160:175], v[120:123], v[88:91], v[160:175]
    v_mfma_f32_32x32x16_bf16 v[160:175], v[124:127], v[92:95], v[160:175]
    s_barrier
    s_setprio 0
    s_nop 9
    v_exp_f32 v160, v160
    v_exp_f32 v161, v161
    v_exp_f32 v162, v162
    v_cvt_pk_bf16_f32 v176, v160, v161
    v_exp_f32 v163, v163
    v_exp_f32 v164, v164
    v_cvt_pk_bf16_f32 v177, v162, v163
    v_exp_f32 v165, v165
    v_exp_f32 v166, v166
    v_cvt_pk_bf16_f32 v178, v164, v165
    v_exp_f32 v167, v167
    v_exp_f32 v168, v168
    v_cvt_pk_bf16_f32 v179, v166, v167
    v_exp_f32 v169, v169
    v_or3_b32 v203, v176, v177, v178
    v_exp_f32 v170, v170
    v_cvt_pk_bf16_f32 v180, v168, v169
    v_exp_f32 v171, v171
    v_exp_f32 v172, v172
    v_cvt_pk_bf16_f32 v181, v170, v171
    v_exp_f32 v173, v173
    v_or3_b32 v203, v203, v179, v180
    v_exp_f32 v174, v174
    v_cvt_pk_bf16_f32 v182, v172, v173
    v_exp_f32 v175, v175
    v_or3_b32 v203, v203, v181, v182
    v_cvt_pk_bf16_f32 v183, v174, v175
    v_or_b32 v203, v203, v183
    v_and_b32 v203, 0x40004000, v203
    v_cmp_ne_u32 vcc, 0, v203
    s_cbranch_vccz L_nors7
    s_call_b64 s[58:59], L_rescale
L_nors7:
    v_permlane16_swap_b32 v248, v249
    v_mov_b32 v201, v248
    v_add_f32 v201, v201, v160
    v_add_f32 v201, v201, v161
    v_add_f32 v201, v201, v162
    v_add_f32 v201, v201, v163
    v_add_f32 v201, v201, v164
    v_add_f32 v201, v201, v165
    v_add_f32 v201, v201, v166
    v_add_f32 v201, v201, v167
    v_add_f32 v201, v201, v168
    v_add_f32 v201, v201, v169
    v_add_f32 v201, v201, v170
    v_add_f32 v201, v201, v171
    v_add_f32 v201, v201, v172
    v_add_f32 v201, v201, v173
    v_add_f32 v201, v201, v174
    v_add_f32 v201, v201, v175
    v_mov_b32 v204, v201
    s_nop 1
    v_permlane32_swap_b32 v204, v201
    v_add_f32 v201, v201, v204
    ds_write_b64 v225, v[200:201]
    s_waitcnt lgkmcnt(0)
    s_barrier
    s_setprio 1
    s_lshl_b32 s49, s44, 13
    v_add_u32 v212, s49, v223
    v_add_u32 v213, 0x20000, v212
    s_cmp_eq_u32 s45, 0
    s_cbranch_scc0 L_g2fin
    v_mfma_f32_32x32x16_bf16 v[32:47], v[136:139], v[176:179], v[32:47]
    v_mfma_f32_32x32x16_bf16 v[48:63], v[140:143], v[176:179], v[48:63]
    v_mfma_f32_32x32x16_bf16 v[32:47], v[152:155], v[180:183], v[32:47]
    v_mfma_f32_32x32x16_bf16 v[48:63], v[156:159], v[180:183], v[48:63]
    v_mfma_f32_32x32x16_bf16 v[0:15], v[128:131], v[176:179], v[0:15]
    v_mfma_f32_32x32x16_bf16 v[16:31], v[132:135], v[176:179], v[16:31]
    v_mfma_f32_32x32x16_bf16 v[0:15], v[144:147], v[180:183], v[0:15]
    s_nop 7
    ds_write_b128 v213, v[32:35] offset:0
    ds_write_b128 v213, v[36:39] offset:1024
    ds_write_b128 v213, v[40:43] offset:2048
    ds_write_b128 v213, v[44:47] offset:3072
    v_mfma_f32_32x32x16_bf16 v[16:31], v[148:151], v[180:183], v[16:31]
    ds_write_b128 v213, v[48:51] offset:4096
    ds_write_b128 v213, v[52:55] offset:5120
    ds_write_b128 v213, v[56:59] offset:6144
    ds_write_b128 v213, v[60:63] offset:7168
    s_waitcnt lgkmcnt(0)
    s_barrier
    ds_read_b64 v[204:205], v226
    v_mov_b32 v221, 0x8000
    ds_read_b32 v222, v221
    s_waitcnt lgkmcnt(0)
    v_min_f32 v208, v200, v204
    v_sub_f32 v206, v208, v200
    v_sub_f32 v207, v208, v204
    v_exp_f32 v206, v206
    v_exp_f32 v207, v207
    v_mov_b32 v200, v208
    v_mul_f32 v201, v206, v201
    v_fmac_f32 v201, v207, v205
    v_readfirstlane_b32 s53, v222
    s_lshl_b32 s55, s44, 3
    s_lshl_b32 s54, s45, 2
    s_add_u32 s55, s55, s54
    s_add_u32 s55, s55, s42
    s_lshr_b32 s54, s53, s55
    s_and_b32 s54, s54, 1
    v_mov_b32 v220, s54
    v_mov_b32 v221, 0
    s_mov_b64 exec, 1
    s_waitcnt vmcnt(0)
    buffer_store_dword v220, v221, s[32:35], s100 offen sc1
    s_mov_b64 exec, -1
    buffer_store_dwordx2 v[200:201], v224, s[32:35], s97 offen sc1
    v_mul_f32 v0, v206, v0
    v_mul_f32 v1, v206, v1
    v_mul_f32 v2, v206, v2
    v_mul_f32 v3, v206, v3
    v_mul_f32 v4, v206, v4
    v_mul_f32 v5, v206, v5
    v_mul_f32 v6, v206, v6
    v_mul_f32 v7, v206, v7
    v_mul_f32 v8, v206, v8
    v_mul_f32 v9, v206, v9
    v_mul_f32 v10, v206, v10
    v_mul_f32 v11, v206, v11
    v_mul_f32 v12, v206, v12
    v_mul_f32 v13, v206, v13
    v_mul_f32 v14, v206, v14
    v_mul_f32 v15, v206, v15
    v_mul_f32 v16, v206, v16
    v_mul_f32 v17, v206, v17
    v_mul_f32 v18, v206, v18
    v_mul_f32 v19, v206, v19
    v_mul_f32 v20, v206, v20
    v_mul_f32 v21, v206, v21
    v_mul_f32 v22, v206, v22
    v_mul_f32 v23, v206, v23
    v_mul_f32 v24, v206, v24
    v_mul_f32 v25, v206, v25
    v_mul_f32 v26, v206, v26
    v_mul_f32 v27, v206, v27
    v_mul_f32 v28, v206, v28
    v_mul_f32 v29, v206, v29
    v_mul_f32 v30, v206, v30
    v_mul_f32 v31, v206, v31
    s_barrier
    ds_read_b128 v[96:99], v212 offset:0
    ds_read_b128 v[100:103], v212 offset:1024
    ds_read_b128 v[104:107], v212 offset:2048
    ds_read_b128 v[108:111], v212 offset:3072
    ds_read_b128 v[112:115], v212 offset:4096
    ds_read_b128 v[116:119], v212 offset:5120
    ds_read_b128 v[120:123], v212 offset:6144
    ds_read_b128 v[124:127], v212 offset:7168
    s_waitcnt lgkmcnt(7)
    v_fmac_f32 v0, v207, v96
    v_fmac_f32 v1, v207, v97
    v_fmac_f32 v2, v207, v98
    v_fmac_f32 v3, v207, v99
    s_waitcnt lgkmcnt(6)
    v_fmac_f32 v4, v207, v100
    v_fmac_f32 v5, v207, v101
    v_fmac_f32 v6, v207, v102
    v_fmac_f32 v7, v207, v103
    s_waitcnt lgkmcnt(5)
    v_fmac_f32 v8, v207, v104
    v_fmac_f32 v9, v207, v105
    v_fmac_f32 v10, v207, v106
    v_fmac_f32 v11, v207, v107
    s_waitcnt lgkmcnt(4)
    v_fmac_f32 v12, v207, v108
    v_fmac_f32 v13, v207, v109
    v_fmac_f32 v14, v207, v110
    v_fmac_f32 v15, v207, v111
    s_waitcnt lgkmcnt(3)
    v_fmac_f32 v16, v207, v112
    v_fmac_f32 v17, v207, v113
    v_fmac_f32 v18, v207, v114
    v_fmac_f32 v19, v207, v115
    s_waitcnt lgkmcnt(2)
    v_fmac_f32 v20, v207, v116
    v_fmac_f32 v21, v207, v117
    v_fmac_f32 v22, v207, v118
    v_fmac_f32 v23, v207, v119
    s_waitcnt lgkmcnt(1)
    v_fmac_f32 v24, v207, v120
    v_fmac_f32 v25, v207, v121
    v_fmac_f32 v26, v207, v122
    v_fmac_f32 v27, v207, v123
    s_waitcnt lgkmcnt(0)
    v_fmac_f32 v28, v207, v124
    v_fmac_f32 v29, v207, v125
    v_fmac_f32 v30, v207, v126
    v_fmac_f32 v31, v207, v127
    s_branch L_fin
L_g2fin:
    ds_read_b64 v[204:205], v226
    v_mov_b32 v221, 0x8000
    ds_read_b32 v222, v221
    ds_read_b128 v[96:99], v213 offset:0
    ds_read_b128 v[100:103], v213 offset:1024
    ds_read_b128 v[104:107], v213 offset:2048
    ds_read_b128 v[108:111], v213 offset:3072
    ds_read_b128 v[112:115], v213 offset:4096
    ds_read_b128 v[116:119], v213 offset:5120
    ds_read_b128 v[120:123], v213 offset:6144
    ds_read_b128 v[124:127], v213 offset:7168
    v_mfma_f32_32x32x16_bf16 v[0:15], v[128:131], v[176:179], v[0:15]
    v_mfma_f32_32x32x16_bf16 v[16:31], v[132:135], v[176:179], v[16:31]
    v_mfma_f32_32x32x16_bf16 v[0:15], v[144:147], v[180:183], v[0:15]
    s_waitcnt lgkmcnt(8)
    v_min_f32 v208, v200, v204
    v_sub_f32 v206, v208, v200
    v_sub_f32 v207, v208, v204
    v_exp_f32 v206, v206
    v_exp_f32 v207, v207
    v_mov_b32 v200, v208
    v_mul_f32 v201, v206, v201
    v_fmac_f32 v201, v207, v205
    v_readfirstlane_b32 s53, v222
    s_lshl_b32 s55, s44, 3
    s_lshl_b32 s54, s45, 2
    s_add_u32 s55, s55, s54
    s_add_u32 s55, s55, s42
    s_lshr_b32 s54, s53, s55
    s_and_b32 s54, s54, 1
    v_mov_b32 v220, s54
    v_mov_b32 v221, 0
    s_mov_b64 exec, 1
    s_waitcnt vmcnt(0)
    buffer_store_dword v220, v221, s[32:35], s100 offen sc1
    s_mov_b64 exec, -1
    buffer_store_dwordx2 v[200:201], v224, s[32:35], s97 offen sc1
    v_mfma_f32_32x32x16_bf16 v[16:31], v[148:151], v[180:183], v[16:31]
    s_waitcnt lgkmcnt(0)
    v_mfma_f32_32x32x16_bf16 v[32:47], v[136:139], v[176:179], v[32:47]
    v_mul_f32 v96, v207, v96
    v_mul_f32 v97, v207, v97
    v_mul_f32 v98, v207, v98
    v_mul_f32 v99, v207, v99
    v_mul_f32 v100, v207, v100
    v_mul_f32 v101, v207, v101
    v_mfma_f32_32x32x16_bf16 v[48:63], v[140:143], v[176:179], v[48:63]
    v_mul_f32 v102, v207, v102
    v_mul_f32 v103, v207, v103
    v_mul_f32 v104, v207, v104
    v_mul_f32 v105, v207, v105
    v_mul_f32 v106, v207, v106
    v_mul_f32 v107, v207, v107
    v_mfma_f32_32x32x16_bf16 v[32:47], v[152:155], v[180:183], v[32:47]
    ds_write_b128 v212, v[0:3] offset:0
    ds_write_b128 v212, v[4:7] offset:1024
    ds_write_b128 v212, v[8:11] offset:2048
    ds_write_b128 v212, v[12:15] offset:3072
    v_mfma_f32_32x32x16_bf16 v[48:63], v[156:159], v[180:183], v[48:63]
    ds_write_b128 v212, v[16:19] offset:4096
    ds_write_b128 v212, v[20:23] offset:5120
    ds_write_b128 v212, v[24:27] offset:6144
    ds_write_b128 v212, v[28:31] offset:7168
    v_mul_f32 v108, v207, v108
    v_mul_f32 v109, v207, v109
    v_mul_f32 v110, v207, v110
    v_mul_f32 v111, v207, v111
    v_mul_f32 v112, v207, v112
    v_mul_f32 v113, v207, v113
    v_mul_f32 v114, v207, v114
    v_mul_f32 v115, v207, v115
    v_mul_f32 v116, v207, v116
    v_mul_f32 v117, v207, v117
    v_mul_f32 v118, v207, v118
    v_mul_f32 v119, v207, v119
    v_mul_f32 v120, v207, v120
    v_mul_f32 v121, v207, v121
    v_mul_f32 v122, v207, v122
    v_mul_f32 v123, v207, v123
    v_mul_f32 v124, v207, v124
    v_mul_f32 v125, v207, v125
    v_mul_f32 v126, v207, v126
    v_mul_f32 v127, v207, v127
    s_waitcnt lgkmcnt(0)
    s_barrier
    v_fma_f32 v0, v206, v32, v96
    v_fma_f32 v1, v206, v33, v97
    v_fma_f32 v2, v206, v34, v98
    v_fma_f32 v3, v206, v35, v99
    v_fma_f32 v4, v206, v36, v100
    v_fma_f32 v5, v206, v37, v101
    v_fma_f32 v6, v206, v38, v102
    v_fma_f32 v7, v206, v39, v103
    v_fma_f32 v8, v206, v40, v104
    v_fma_f32 v9, v206, v41, v105
    v_fma_f32 v10, v206, v42, v106
    v_fma_f32 v11, v206, v43, v107
    v_fma_f32 v12, v206, v44, v108
    v_fma_f32 v13, v206, v45, v109
    v_fma_f32 v14, v206, v46, v110
    v_fma_f32 v15, v206, v47, v111
    v_fma_f32 v16, v206, v48, v112
    v_fma_f32 v17, v206, v49, v113
    v_fma_f32 v18, v206, v50, v114
    v_fma_f32 v19, v206, v51, v115
    v_fma_f32 v20, v206, v52, v116
    v_fma_f32 v21, v206, v53, v117
    v_fma_f32 v22, v206, v54, v118
    v_fma_f32 v23, v206, v55, v119
    v_fma_f32 v24, v206, v56, v120
    v_fma_f32 v25, v206, v57, v121
    v_fma_f32 v26, v206, v58, v122
    v_fma_f32 v27, v206, v59, v123
    v_fma_f32 v28, v206, v60, v124
    v_fma_f32 v29, v206, v61, v125
    v_fma_f32 v30, v206, v62, v126
    v_fma_f32 v31, v206, v63, v127
L_fin:
    s_cmp_eq_u32 s44, s42
    s_cbranch_scc1 L_own
    v_cvt_pk_bf16_f32 v64, v0, v1
    v_cvt_pk_bf16_f32 v65, v2, v3
    v_cvt_pk_bf16_f32 v66, v4, v5
    v_cvt_pk_bf16_f32 v67, v6, v7
    buffer_store_dwordx4 v[64:67], v223, s[32:35], s94 offen offset:0 sc1
    v_cvt_pk_bf16_f32 v68, v8, v9
    v_cvt_pk_bf16_f32 v69, v10, v11
    v_cvt_pk_bf16_f32 v70, v12, v13
    v_cvt_pk_bf16_f32 v71, v14, v15
    buffer_store_dwordx4 v[68:71], v223, s[32:35], s94 offen offset:1024 sc1
    v_cvt_pk_bf16_f32 v72, v16, v17
    v_cvt_pk_bf16_f32 v73, v18, v19
    v_cvt_pk_bf16_f32 v74, v20, v21
    v_cvt_pk_bf16_f32 v75, v22, v23
    buffer_store_dwordx4 v[72:75], v223, s[32:35], s94 offen offset:2048 sc1
    v_cvt_pk_bf16_f32 v76, v24, v25
    v_cvt_pk_bf16_f32 v77, v26, v27
    v_cvt_pk_bf16_f32 v78, v28, v29
    v_cvt_pk_bf16_f32 v79, v30, v31
    buffer_store_dwordx4 v[76:79], v223, s[32:35], s94 offen offset:3072 sc1
    s_branch L_recv
L_own:
    s_lshl_b32 s49, s45, 13
    s_add_u32 s49, s49, 0x10000
    v_add_u32 v84, s49, v223
    ds_write_b128 v84, v[0:3] offset:0
    ds_write_b128 v84, v[4:7] offset:1024
    ds_write_b128 v84, v[8:11] offset:2048
    ds_write_b128 v84, v[12:15] offset:3072
    ds_write_b128 v84, v[16:19] offset:4096
    ds_write_b128 v84, v[20:23] offset:5120
    ds_write_b128 v84, v[24:27] offset:6144
    ds_write_b128 v84, v[28:31] offset:7168
    s_lshl_b32 s49, s45, 9
    s_add_u32 s49, s49, 0x14000
    v_add_u32 v85, s49, v224
    ds_write_b64 v85, v[200:201]
    s_waitcnt vmcnt(0)
L_recv:
    s_waitcnt lgkmcnt(0)
    s_barrier
    s_lshl_b32 s49, s40, 11
    s_add_u32 s49, s49, 0x10000
    v_add_u32 v20, s49, v223
    s_lshl_b32 s49, s45, 9
    s_add_u32 s49, s49, 0x14000
    v_add_u32 v21, s49, v224
    ds_read_b128 v[24:27], v20
    ds_read_b128 v[28:31], v20 offset:1024
    ds_read_b64 v[32:33], v21
    s_lshl_b32 s49, s52, 1
    s_add_u32 s49, s49, s45
    s_lshl_b32 s49, s49, 2
    s_lshl_b32 s56, s44, 10
    s_xor_b32 s54, s42, 1
    s_add_u32 s54, s54, s49
    s_lshl_b32 s5, s54, 9
    s_add_u32 s5, s5, 0x800000
    s_lshl_b32 s9, s54, 12
    s_add_u32 s9, s9, s56
    s_xor_b32 s54, s42, 2
    s_add_u32 s54, s54, s49
    s_lshl_b32 s6, s54, 9
    s_add_u32 s6, s6, 0x800000
    s_lshl_b32 s10, s54, 12
    s_add_u32 s10, s10, s56
    s_xor_b32 s54, s42, 3
    s_add_u32 s54, s54, s49
    s_lshl_b32 s7, s54, 9
    s_add_u32 s7, s7, 0x800000
    s_lshl_b32 s11, s54, 12
    s_add_u32 s11, s11, s56
    v_and_b32 v60, 31, v199
    v_lshlrev_b32 v60, 8, v60
    v_lshrrev_b32 v61, 5, v199
    v_lshl_add_u32 v60, v61, 4, v60
    s_lshl_b32 s49, s52, 13
    s_lshl_b32 s54, s40, 5
    s_add_u32 s49, s49, s54
    s_mov_b32 s56, 0
    s_lshl_b32 s54, s52, 1
    s_add_u32 s54, s54, s45
    s_lshl_b32 s54, s54, 9
    s_add_u32 s54, s54, 0x900000
    v_lshlrev_b32 v21, 7, v199
    s_lshl_b32 s55, s42, 3
    s_lshr_b32 s53, s53, s55
    s_lshl_b32 s55, s45, 2
    s_lshr_b32 s55, s53, s55
    s_and_b32 s55, s55, 15
    s_lshl_b32 s53, 1, s42
    s_mov_b64 exec, 15
L_hint:
    buffer_load_dword v22, v21, s[32:35], s54 offen sc1
    s_add_u32 s56, s56, 1
    s_waitcnt vmcnt(0)
    v_and_b32 v22, 1, v22
    v_cmp_eq_u32 vcc, 1, v22
    s_nop 1
    s_or_b32 s51, vcc_lo, s53
    s_and_b32 s51, s51, 15
    s_cmp_eq_u32 s51, s55
    s_cbranch_scc1 L_hintok
    s_cmp_gt_u32 s56, 0x40000
    s_cbranch_scc1 L_hintok
    s_sleep 4
    s_branch L_hint
L_hintok:
    s_mov_b64 exec, -1
    s_mov_b32 s56, 0
L_poll:
    buffer_load_dwordx2 v[48:49], v224, s[32:35], s5 offen sc1
    buffer_load_dwordx4 v[0:3], v223, s[32:35], s9 offen sc1
    buffer_load_dwordx2 v[50:51], v224, s[32:35], s6 offen sc1
    buffer_load_dwordx4 v[4:7], v223, s[32:35], s10 offen sc1
    buffer_load_dwordx2 v[52:53], v224, s[32:35], s7 offen sc1
    buffer_load_dwordx4 v[8:11], v223, s[32:35], s11 offen sc1
    s_add_u32 s56, s56, 1
    s_waitcnt vmcnt(0) lgkmcnt(0)
    v_max3_u32 v22, v0, v1, v2
    v_max3_u32 v23, v3, v4, v5
    v_max3_u32 v22, v22, v6, v7
    v_max3_u32 v23, v23, v8, v9
    v_max3_u32 v22, v22, v10, v11
    v_max3_u32 v23, v23, v48, v49
    v_max3_u32 v22, v22, v50, v51
    v_max3_u32 v23, v23, v52, v53
    v_max_u32 v22, v22, v23
    v_cmp_eq_u32 vcc, -1, v22
    s_cmp_gt_u32 s56, 0x4000
    s_cbranch_scc1 L_pollok
    s_cbranch_vccz L_pollok
    s_sleep 4
    s_branch L_poll
L_pollok:
    v_min3_f32 v54, v48, v50, v52
    v_min_f32 v54, v54, v32
    v_sub_f32 v55, v54, v32
    v_sub_f32 v56, v54, v48
    v_sub_f32 v57, v54, v50
    v_sub_f32 v58, v54, v52
    v_exp_f32 v55, v55
    v_exp_f32 v56, v56
    v_exp_f32 v57, v57
    v_exp_f32 v58, v58
    v_mul_f32 v59, v55, v33
    v_fmac_f32 v59, v56, v49
    v_fmac_f32 v59, v57, v51
    v_fmac_f32 v59, v58, v53
    v_rcp_f32 v59, v59
    v_mul_f32 v24, v55, v24
    v_mul_f32 v25, v55, v25
    v_mul_f32 v26, v55, v26
    v_mul_f32 v27, v55, v27
    v_mul_f32 v28, v55, v28
    v_mul_f32 v29, v55, v29
    v_mul_f32 v30, v55, v30
    v_mul_f32 v31, v55, v31
    v_lshlrev_b32 v62, 16, v0
    v_and_b32 v63, 0xffff0000, v0
    v_fmac_f32 v24, v56, v62
    v_fmac_f32 v25, v56, v63
    v_lshlrev_b32 v62, 16, v1
    v_and_b32 v63, 0xffff0000, v1
    v_fmac_f32 v26, v56, v62
    v_fmac_f32 v27, v56, v63
    v_lshlrev_b32 v62, 16, v2
    v_and_b32 v63, 0xffff0000, v2
    v_fmac_f32 v28, v56, v62
    v_fmac_f32 v29, v56, v63
    v_lshlrev_b32 v62, 16, v3
    v_and_b32 v63, 0xffff0000, v3
    v_fmac_f32 v30, v56, v62
    v_fmac_f32 v31, v56, v63
    v_lshlrev_b32 v62, 16, v4
    v_and_b32 v63, 0xffff0000, v4
    v_fmac_f32 v24, v57, v62
    v_fmac_f32 v25, v57, v63
    v_lshlrev_b32 v62, 16, v5
    v_and_b32 v63, 0xffff0000, v5
    v_fmac_f32 v26, v57, v62
    v_fmac_f32 v27, v57, v63
    v_lshlrev_b32 v62, 16, v6
    v_and_b32 v63, 0xffff0000, v6
    v_fmac_f32 v28, v57, v62
    v_fmac_f32 v29, v57, v63
    v_lshlrev_b32 v62, 16, v7
    v_and_b32 v63, 0xffff0000, v7
    v_fmac_f32 v30, v57, v62
    v_fmac_f32 v31, v57, v63
    v_lshlrev_b32 v62, 16, v8
    v_and_b32 v63, 0xffff0000, v8
    v_fmac_f32 v24, v58, v62
    v_fmac_f32 v25, v58, v63
    v_lshlrev_b32 v62, 16, v9
    v_and_b32 v63, 0xffff0000, v9
    v_fmac_f32 v26, v58, v62
    v_fmac_f32 v27, v58, v63
    v_lshlrev_b32 v62, 16, v10
    v_and_b32 v63, 0xffff0000, v10
    v_fmac_f32 v28, v58, v62
    v_fmac_f32 v29, v58, v63
    v_lshlrev_b32 v62, 16, v11
    v_and_b32 v63, 0xffff0000, v11
    v_fmac_f32 v30, v58, v62
    v_fmac_f32 v31, v58, v63
    v_mul_f32 v24, v59, v24
    v_mul_f32 v25, v59, v25
    v_mul_f32 v26, v59, v26
    v_mul_f32 v27, v59, v27
    v_mul_f32 v28, v59, v28
    v_mul_f32 v29, v59, v29
    v_mul_f32 v30, v59, v30
    v_mul_f32 v31, v59, v31
    v_cvt_pk_bf16_f32 v64, v24, v25
    v_cvt_pk_bf16_f32 v65, v26, v27
    v_cvt_pk_bf16_f32 v66, v28, v29
    v_cvt_pk_bf16_f32 v67, v30, v31
    s_nop 0
    v_permlane32_swap_b32 v64, v66
    v_permlane32_swap_b32 v65, v67
    buffer_store_dwordx4 v[64:67], v60, s[28:31], s49 offen
L_end:
    s_endpgm
L_rescale:
    s_nop 1
    v_mfma_f32_32x32x16_bf16 v[160:175], v[96:99], v[64:67], 0
    v_mfma_f32_32x32x16_bf16 v[160:175], v[100:103], v[68:71], v[160:175]
    v_mfma_f32_32x32x16_bf16 v[160:175], v[104:107], v[72:75], v[160:175]
    v_mfma_f32_32x32x16_bf16 v[160:175], v[108:111], v[76:79], v[160:175]
    v_mfma_f32_32x32x16_bf16 v[160:175], v[112:115], v[80:83], v[160:175]
    v_mfma_f32_32x32x16_bf16 v[160:175], v[116:119], v[84:87], v[160:175]
    v_mfma_f32_32x32x16_bf16 v[160:175], v[120:123], v[88:91], v[160:175]
    v_mfma_f32_32x32x16_bf16 v[160:175], v[124:127], v[92:95], v[160:175]
    s_nop 11
    v_max3_f32 v203, v160, v161, v162
    v_max3_f32 v203, v203, v163, v164
    v_max3_f32 v203, v203, v165, v166
    v_max3_f32 v203, v203, v167, v168
    v_max3_f32 v203, v203, v169, v170
    v_max3_f32 v203, v203, v171, v172
    v_max3_f32 v203, v203, v173, v174
    v_max_f32 v203, v203, v175
    v_mov_b32 v204, v203
    s_nop 1
    v_permlane32_swap_b32 v204, v203
    v_max_f32 v204, v203, v204
    v_sub_f32 v204, 0xc0a00000, v204
    v_min_f32 v204, v204, v200
    v_sub_f32 v205, v204, v200
    v_exp_f32 v205, v205
    v_mov_b32 v200, v204
    v_mov_b32 v232, v200
    v_mov_b32 v233, v200
    v_mov_b32 v234, v200
    v_mov_b32 v235, v200
    v_mov_b32 v236, v200
    v_mov_b32 v237, v200
    v_mov_b32 v238, v200
    v_mov_b32 v239, v200
    v_mov_b32 v240, v200
    v_mov_b32 v241, v200
    v_mov_b32 v242, v200
    v_mov_b32 v243, v200
    v_mov_b32 v244, v200
    v_mov_b32 v245, v200
    v_mov_b32 v246, v200
    v_mov_b32 v247, v200
    v_mov_b32 v206, v205
    v_mov_b32 v207, v205
    s_nop 1
    v_permlane16_swap_b32 v206, v207
    v_mul_f32 v201, v205, v201
    v_mul_f32 v248, v205, v248
    v_mul_f32 v249, v207, v249
    v_mul_f32 v0, v205, v0
    v_mul_f32 v1, v205, v1
    v_mul_f32 v2, v205, v2
    v_mul_f32 v3, v205, v3
    v_mul_f32 v4, v205, v4
    v_mul_f32 v5, v205, v5
    v_mul_f32 v6, v205, v6
    v_mul_f32 v7, v205, v7
    v_mul_f32 v8, v205, v8
    v_mul_f32 v9, v205, v9
    v_mul_f32 v10, v205, v10
    v_mul_f32 v11, v205, v11
    v_mul_f32 v12, v205, v12
    v_mul_f32 v13, v205, v13
    v_mul_f32 v14, v205, v14
    v_mul_f32 v15, v205, v15
    v_mul_f32 v16, v205, v16
    v_mul_f32 v17, v205, v17
    v_mul_f32 v18, v205, v18
    v_mul_f32 v19, v205, v19
    v_mul_f32 v20, v205, v20
    v_mul_f32 v21, v205, v21
    v_mul_f32 v22, v205, v22
    v_mul_f32 v23, v205, v23
    v_mul_f32 v24, v205, v24
    v_mul_f32 v25, v205, v25
    v_mul_f32 v26, v205, v26
    v_mul_f32 v27, v205, v27
    v_mul_f32 v28, v205, v28
    v_mul_f32 v29, v205, v29
    v_mul_f32 v30, v205, v30
    v_mul_f32 v31, v205, v31
    v_mul_f32 v32, v205, v32
    v_mul_f32 v33, v205, v33
    v_mul_f32 v34, v205, v34
    v_mul_f32 v35, v205, v35
    v_mul_f32 v36, v205, v36
    v_mul_f32 v37, v205, v37
    v_mul_f32 v38, v205, v38
    v_mul_f32 v39, v205, v39
    v_mul_f32 v40, v205, v40
    v_mul_f32 v41, v205, v41
    v_mul_f32 v42, v205, v42
    v_mul_f32 v43, v205, v43
    v_mul_f32 v44, v205, v44
    v_mul_f32 v45, v205, v45
    v_mul_f32 v46, v205, v46
    v_mul_f32 v47, v205, v47
    v_mul_f32 v48, v205, v48
    v_mul_f32 v49, v205, v49
    v_mul_f32 v50, v205, v50
    v_mul_f32 v51, v205, v51
    v_mul_f32 v52, v205, v52
    v_mul_f32 v53, v205, v53
    v_mul_f32 v54, v205, v54
    v_mul_f32 v55, v205, v55
    v_mul_f32 v56, v205, v56
    v_mul_f32 v57, v205, v57
    v_mul_f32 v58, v205, v58
    v_mul_f32 v59, v205, v59
    v_mul_f32 v60, v205, v60
    v_mul_f32 v61, v205, v61
    v_mul_f32 v62, v205, v62
    v_mul_f32 v63, v205, v63
    v_add_f32 v160, v160, v200
    v_add_f32 v161, v161, v200
    v_exp_f32 v160, v160
    v_add_f32 v162, v162, v200
    v_exp_f32 v161, v161
    v_add_f32 v163, v163, v200
    v_exp_f32 v162, v162
    v_add_f32 v164, v164, v200
    v_cvt_pk_bf16_f32 v176, v160, v161
    v_exp_f32 v163, v163
    v_add_f32 v165, v165, v200
    v_exp_f32 v164, v164
    v_add_f32 v166, v166, v200
    v_cvt_pk_bf16_f32 v177, v162, v163
    v_exp_f32 v165, v165
    v_add_f32 v167, v167, v200
    v_exp_f32 v166, v166
    v_add_f32 v168, v168, v200
    v_cvt_pk_bf16_f32 v178, v164, v165
    v_exp_f32 v167, v167
    v_add_f32 v169, v169, v200
    v_exp_f32 v168, v168
    v_add_f32 v170, v170, v200
    v_cvt_pk_bf16_f32 v179, v166, v167
    v_exp_f32 v169, v169
    v_add_f32 v171, v171, v200
    v_exp_f32 v170, v170
    v_add_f32 v172, v172, v200
    v_cvt_pk_bf16_f32 v180, v168, v169
    v_exp_f32 v171, v171
    v_add_f32 v173, v173, v200
    v_exp_f32 v172, v172
    v_add_f32 v174, v174, v200
    v_cvt_pk_bf16_f32 v181, v170, v171
    v_exp_f32 v173, v173
    v_add_f32 v175, v175, v200
    v_exp_f32 v174, v174
    v_cvt_pk_bf16_f32 v182, v172, v173
    v_exp_f32 v175, v175
    s_nop 0
    v_cvt_pk_bf16_f32 v183, v174, v175
    s_nop 1
    s_setpc_b64 s[58:59]
L_codeend:
.section .rodata,"a"
.p2align 6
.amdhsa_kernel standalone__gqa_softmax__near_ridge_kernel
  .amdhsa_next_free_vgpr 256
  .amdhsa_next_free_sgpr 102
  .amdhsa_accum_offset 256
  .amdhsa_group_segment_fixed_size 0
  .amdhsa_kernarg_size 48
  .amdhsa_user_sgpr_count 2
  .amdhsa_user_sgpr_kernarg_segment_ptr 1
  .amdhsa_system_sgpr_workgroup_id_x 1
.end_amdhsa_kernel
```
